```python
import torch

def _softmax(x, axis=-1):
    return torch.softmax(x, dim=axis)
def _gelu(x):
    return torch.nn.functional.gelu(x, approximate="tanh")
def _silu(x):
    return torch.nn.functional.silu(x)
def _sigmoid(x):
    return torch.sigmoid(x)
def _layernorm(x, axis=-1, eps=1e-5):
    m = x.mean(dim=axis, keepdim=True)
    v = x.var(dim=axis, keepdim=True, unbiased=False)
    return (x - m) / torch.sqrt(v + eps)
def _scatter_add(tgt, idx, src, axis=0):
    return tgt.clone().index_add_(axis, idx, src)
def _segment_sum(src, seg, n):
    out = torch.zeros((n,) + src.shape[1:], dtype=src.dtype)
    return out.index_add_(0, seg, src)
def _pad(x, pw):
    flat = tuple(v for pair in reversed(pw) for v in pair)
    return torch.nn.functional.pad(x, flat)

kernel_name = 'standalone__deepnorm__sampling'

def setup_inputs():

    _w = (lambda a: (lambda t: t.to(torch.bfloat16) if t.is_floating_point() else t)(torch.as_tensor(a)))
    B, S, D = 1024, 32, 512
    return {
        "x": _w((lambda *s: torch.randn(*s, dtype=torch.bfloat16) * 0.05)(B, S, D)),
        "f": _w((lambda *s: torch.randn(*s, dtype=torch.bfloat16) * 0.05)(B, S, D)),
        "g": _w((lambda *s: torch.randn(*s, dtype=torch.bfloat16) * 0.05)(D) + 1.0),
        "b": _w((lambda *s: torch.randn(*s, dtype=torch.bfloat16) * 0.4)(D)),
        "alpha": _w(float(2.0)),
    }

def reference(x, f, g, b, alpha):
    return _layernorm(alpha * x + f, axis=-1) * g + b
```

```asm
; @launch grid=(8192,1,1) block=(256,1,1) lds=0
.amdgcn_target "amdgcn-amd-amdhsa--gfx950"
.text
.globl standalone__deepnorm__sampling_kernel
.p2align 8
.type standalone__deepnorm__sampling_kernel,@function
standalone__deepnorm__sampling_kernel:
    s_load_dwordx16 s[16:31], s[0:1], 0
    s_cmpk_lt_u32 s2, 192
    s_cbranch_scc0 L_common
    s_lshr_b32 s11, s2, 6
    v_readfirstlane_b32 s10, v0
    s_movk_i32 s9, 0x2000
    s_lshl_b32 s12, s2, 12
    s_lshr_b32 s13, s12, 2
    s_and_b32 s13, s13, s9
    s_xor_b32 s12, s12, s13
    s_bitset1_b32 s12, 24
    s_cmp_lg_u32 s10, 0
    s_cbranch_scc1 L_common
    v_mov_b32 v4, s12
    v_xor_b32 v5, s9, v4
    s_setprio 3
    s_cmp_eq_u32 s11, 1
    s_waitcnt lgkmcnt(0)
    s_cselect_b64 s[14:15], s[18:19], s[16:17]
    s_cmp_eq_u32 s11, 2
    s_cselect_b64 s[14:15], s[26:27], s[14:15]
    global_load_dword v6, v4, s[14:15] nt
    global_load_dword v7, v5, s[14:15] offset:256 nt
    s_waitcnt vmcnt(1)
    s_nop 7
    s_getreg_b32 s36, hwreg(HW_REG_IB_STS, 0, 4)
    s_lshr_b32 s13, s12, 1
    s_xor_b32 s13, s13, s12
    s_lshr_b32 s13, s13, 9
    s_and_b32 s13, s13, 16
    s_lshl2_add_u32 s11, s11, s13
    s_lshl_b32 s6, s2, 6
    s_and_b32 s6, s6, 0xc0
    v_mov_b32 v8, s6
    s_and_b32 s13, s2, 60
    s_cmp_eq_u32 s13, 60
    s_cselect_b32 s10, 0, 1
    s_cmp_lg_u32 s36, 0
    s_cselect_b32 s12, 0, 16
    s_xor_b32 s12, s12, s11
    s_lshl_b32 s12, s10, s12
    v_mov_b32 v5, s12
    s_mov_b64 exec, 1
    global_atomic_add v8, v5, s[28:29] sc1
    s_mov_b64 exec, -1
    s_setprio 0
L_common:
    s_cmpk_ge_u32 s2, 8192
    s_cbranch_scc1 L_end
    s_cmpk_lt_u32 s2, 2048
    s_cbranch_scc0 L_calc
    s_waitcnt lgkmcnt(0)
L_calc:
    s_and_b32 s6, s2, 3
    s_and_b32 s7, s2, 0x1e02
    s_add_u32 s5, s6, s7
    s_and_b32 s7, s2, 0x78
    s_lshl2_add_u32 s5, s7, s5
    s_bfe_u32 s13, s2, 0x10003
    s_xor_b32 s5, s5, s13
    s_lshl_b32 s5, s5, 12
    s_and_b32 s7, s2, 0x180
    s_lshl3_add_u32 s5, s7, s5
    s_lshr_b32 s7, s2, 7
    s_xor_b32 s7, s7, s2
    s_lshr_b32 s8, s2, 2
    s_lshl_b32 s6, s6, 6
    v_lshlrev_b32 v2, 4, v0
    v_and_b32 v1, 0xc0, v0
    v_and_b32 v2, 0x3f0, v2
    v_lshl_add_u32 v1, v1, 9, v2
    s_cmpk_lt_u32 s2, 2048
    s_waitcnt lgkmcnt(0)
    s_load_dword s32, s[24:25], 0
    s_cbranch_scc1 L_gb
    s_load_dword s9, s[28:29], s6
L_gb:
    global_load_dwordx4 v[16:19], v2, s[20:21]
    global_load_dwordx4 v[24:27], v2, s[22:23]
    s_cbranch_scc1 L_go
    s_bfe_u32 s10, s16, 0x1000c
    s_bfe_u32 s11, s18, 0x1000c
    s_bfe_u32 s12, s26, 0x1000c
    s_lshl4_add_u32 s11, s12, s11
    s_lshl4_add_u32 s10, s11, s10
    s_mul_i32 s10, s10, s13
    s_mul_i32 s10, s10, 0x80008
    s_xor_b32 s14, s10, 0x888
    s_xor_b32 s15, s10, 0x8880000
    s_lshl_b32 s13, s13, 4
    s_xor_b32 s13, s13, 31
    s_waitcnt lgkmcnt(0)
L_decide:
    s_bitcmp1_b32 s9, s13
    s_cbranch_scc1 L_go
    s_and_b32 s10, s9, s14
    s_bcnt1_i32_b32 s10, s10
    s_and_b32 s12, s9, s15
    s_bcnt1_i32_b32 s12, s12
    s_or_b32 s10, s10, s12
    s_bitcmp1_b32 s10, 1
    s_cbranch_scc0 L_slow
    s_lshl_b32 s8, s12, 1
L_go:
    s_xor_b32 s7, s7, s8
    s_and_b32 s7, s7, 4
    s_lshl_b32 s7, s7, 11
    s_or_b32 s5, s5, s7
    v_add_u32 v1, s5, v1
    global_load_dwordx4 v[28:31], v1, s[16:17] nt
    global_load_dwordx4 v[32:35], v1, s[18:19] nt
    s_mov_b32 s34, 0xffff0000
    s_mov_b32 s35, 0x3b000000
    v_mov_b32 v3, 0x3727c5ac
    s_waitcnt vmcnt(2) lgkmcnt(0)
    s_lshl_b32 s32, s32, 16
    v_lshlrev_b32 v12, 16, v16
    v_and_b32 v16, s34, v16
    v_lshlrev_b32 v20, 16, v24
    v_and_b32 v24, s34, v24
    v_lshlrev_b32 v13, 16, v17
    v_and_b32 v17, s34, v17
    v_lshlrev_b32 v21, 16, v25
    v_and_b32 v25, s34, v25
    v_lshlrev_b32 v14, 16, v18
    v_and_b32 v18, s34, v18
    v_lshlrev_b32 v22, 16, v26
    v_and_b32 v26, s34, v26
    v_lshlrev_b32 v15, 16, v19
    v_and_b32 v19, s34, v19
    v_lshlrev_b32 v23, 16, v27
    v_and_b32 v27, s34, v27
    s_waitcnt vmcnt(1)
    v_lshlrev_b32 v4, 16, v28
    v_lshlrev_b32 v5, 16, v29
    v_lshlrev_b32 v6, 16, v30
    v_lshlrev_b32 v7, 16, v31
    v_and_b32 v28, s34, v28
    v_and_b32 v29, s34, v29
    v_and_b32 v30, s34, v30
    v_and_b32 v31, s34, v31
    s_waitcnt vmcnt(0)
    v_lshlrev_b32 v8, 16, v32
    v_lshlrev_b32 v9, 16, v33
    v_lshlrev_b32 v10, 16, v34
    v_lshlrev_b32 v11, 16, v35
    v_and_b32 v32, s34, v32
    v_and_b32 v33, s34, v33
    v_and_b32 v34, s34, v34
    v_and_b32 v35, s34, v35
    v_pk_fma_f32 v[32:33], v[28:29], s[32:33], v[32:33] op_sel_hi:[1,0,1]
    v_pk_fma_f32 v[34:35], v[30:31], s[32:33], v[34:35] op_sel_hi:[1,0,1]
    v_pk_fma_f32 v[28:29], v[4:5], s[32:33], v[8:9] op_sel_hi:[1,0,1]
    v_pk_fma_f32 v[30:31], v[6:7], s[32:33], v[10:11] op_sel_hi:[1,0,1]
    v_pk_add_f32 v[6:7], v[32:33], v[34:35]
    v_pk_add_f32 v[4:5], v[28:29], v[30:31]
    v_pk_add_f32 v[4:5], v[4:5], v[6:7]
    v_add_f32 v8, v4, v5
    s_nop 1
    v_add_f32_dpp v8, v8, v8 quad_perm:[1,0,3,2] row_mask:0xf bank_mask:0xf
    s_nop 1
    v_add_f32_dpp v8, v8, v8 quad_perm:[2,3,0,1] row_mask:0xf bank_mask:0xf
    s_nop 1
    v_add_f32_dpp v8, v8, v8 row_half_mirror row_mask:0xf bank_mask:0xf
    s_nop 1
    v_add_f32_dpp v8, v8, v8 row_mirror row_mask:0xf bank_mask:0xf
    s_nop 1
    v_add_f32_dpp v8, v8, v8 row_bcast:15 row_mask:0xa bank_mask:0xf
    s_nop 1
    v_add_f32_dpp v8, v8, v8 row_bcast:31 row_mask:0xc bank_mask:0xf
    v_mul_f32 v8, s35, v8
    s_nop 0
    v_readlane_b32 s36, v8, 63
    s_nop 1
    v_pk_add_f32 v[28:29], v[28:29], s[36:37] op_sel_hi:[1,0] neg_lo:[0,1] neg_hi:[0,1]
    v_pk_add_f32 v[30:31], v[30:31], s[36:37] op_sel_hi:[1,0] neg_lo:[0,1] neg_hi:[0,1]
    v_pk_add_f32 v[32:33], v[32:33], s[36:37] op_sel_hi:[1,0] neg_lo:[0,1] neg_hi:[0,1]
    v_pk_add_f32 v[34:35], v[34:35], s[36:37] op_sel_hi:[1,0] neg_lo:[0,1] neg_hi:[0,1]
    v_pk_mul_f32 v[4:5], v[28:29], v[28:29]
    v_pk_fma_f32 v[4:5], v[30:31], v[30:31], v[4:5]
    v_pk_fma_f32 v[4:5], v[32:33], v[32:33], v[4:5]
    v_pk_fma_f32 v[4:5], v[34:35], v[34:35], v[4:5]
    v_add_f32 v8, v4, v5
    v_pk_mul_f32 v[28:29], v[28:29], v[12:13]
    s_nop 0
    v_add_f32_dpp v8, v8, v8 quad_perm:[1,0,3,2] row_mask:0xf bank_mask:0xf
    v_pk_mul_f32 v[30:31], v[30:31], v[14:15]
    s_nop 0
    v_add_f32_dpp v8, v8, v8 quad_perm:[2,3,0,1] row_mask:0xf bank_mask:0xf
    v_pk_mul_f32 v[32:33], v[32:33], v[16:17]
    s_nop 0
    v_add_f32_dpp v8, v8, v8 row_half_mirror row_mask:0xf bank_mask:0xf
    v_pk_mul_f32 v[34:35], v[34:35], v[18:19]
    s_nop 0
    v_add_f32_dpp v8, v8, v8 row_mirror row_mask:0xf bank_mask:0xf
    s_nop 1
    v_add_f32_dpp v8, v8, v8 row_bcast:15 row_mask:0xa bank_mask:0xf
    s_nop 1
    v_add_f32_dpp v8, v8, v8 row_bcast:31 row_mask:0xc bank_mask:0xf
    v_fma_f32 v8, v8, s35, v3
    v_rsq_f32 v8, v8
    s_nop 1
    v_readlane_b32 s36, v8, 63
    s_nop 1
    v_pk_fma_f32 v[28:29], v[28:29], s[36:37], v[20:21] op_sel_hi:[1,0,1]
    v_pk_fma_f32 v[30:31], v[30:31], s[36:37], v[22:23] op_sel_hi:[1,0,1]
    v_pk_fma_f32 v[32:33], v[32:33], s[36:37], v[24:25] op_sel_hi:[1,0,1]
    v_pk_fma_f32 v[34:35], v[34:35], s[36:37], v[26:27] op_sel_hi:[1,0,1]
    v_cvt_pk_bf16_f32 v28, v28, v32
    v_cvt_pk_bf16_f32 v29, v29, v33
    v_cvt_pk_bf16_f32 v30, v30, v34
    v_cvt_pk_bf16_f32 v31, v31, v35
    global_store_dwordx4 v1, v[28:31], s[26:27] sc0 sc1
L_end:
    s_endpgm
L_slow:
    v_mov_b32 v4, s6
    s_add_u32 s6, s6, 0x10000
    v_and_b32 v4, 0xc0, v4
    s_cmp_ge_u32 s6, 0x400000
    s_cbranch_scc1 L_force
    s_cmp_lt_u32 s6, 0x20000
    s_cbranch_scc1 L_rd
    s_sleep 16
L_rd:
    global_load_dword v5, v4, s[28:29] sc1
    s_waitcnt vmcnt(0)
    v_readfirstlane_b32 s9, v5
    s_nop 3
    s_branch L_decide
L_force:
    s_mov_b32 s10, s9
    s_bitset1_b32 s10, s13
    v_mov_b32 v6, s10
    v_mov_b32 v7, s9
    s_mov_b64 exec, 1
    global_atomic_cmpswap v5, v4, v[6:7], s[28:29] sc0 sc1
    s_waitcnt vmcnt(0)
    v_readfirstlane_b32 s10, v5
    s_mov_b64 exec, -1
    s_nop 3
    s_cmp_eq_u32 s10, s9
    s_cbranch_scc1 L_go
    s_mov_b32 s9, s10
    s_branch L_decide
.section .rodata,"a"
.p2align 6
.amdhsa_kernel standalone__deepnorm__sampling_kernel
  .amdhsa_next_free_vgpr 36
  .amdhsa_next_free_sgpr 40
  .amdhsa_accum_offset 36
  .amdhsa_group_segment_fixed_size 0
  .amdhsa_kernarg_size 64
  .amdhsa_user_sgpr_count 2
  .amdhsa_user_sgpr_kernarg_segment_ptr 1
  .amdhsa_system_sgpr_workgroup_id_x 1
  .amdhsa_float_denorm_mode_32 3
.end_amdhsa_kernel
```
